```python
import torch

def _softmax(x, axis=-1):
    return torch.softmax(x, dim=axis)

def _gelu(x):
    return torch.nn.functional.gelu(x, approximate='tanh')

def _silu(x):
    return torch.nn.functional.silu(x)

def _sigmoid(x):
    return torch.sigmoid(x)

def _layernorm(x, axis=-1, eps=1e-05):
    m = x.mean(dim=axis, keepdim=True)
    v = x.var(dim=axis, keepdim=True, unbiased=False)
    return (x - m) / torch.sqrt(v + eps)

def _scatter_add(tgt, idx, src, axis=0):
    return tgt.clone().index_add_(axis, idx, src)

def _segment_sum(src, seg, n):
    out = torch.zeros((n,) + src.shape[1:], dtype=src.dtype)
    return out.index_add_(0, seg, src)

def _pad(x, pw):
    flat = tuple((v for pair in reversed(pw) for v in pair))
    return torch.nn.functional.pad(x, flat)
kernel_name = 'standalone__tree_speculative_verify_tree_attention_over_candidate_token_tree__decode'

def setup_inputs():

    _w = lambda a: (lambda t: t.to(torch.bfloat16) if t.is_floating_point() else t)(torch.as_tensor(a))
    B, Hq, Hkv, T, C, D = (2, 32, 16, 1, 16384, 128)
    tree_mask = torch.zeros((B, T, T), dtype=float)
    for b in range(B):
        parent = torch.zeros(T, dtype=torch.int64)
        for i in range(1, T):
            parent[i] = int(torch.randint(0, i, (1,)).item())
        for i in range(T):
            j = i
            tree_mask[b, i, j] = 1.0
            while j > 0:
                j = parent[j]
                tree_mask[b, i, j] = 1.0
    return {'q': _w((lambda *s: torch.randn(*s, dtype=torch.bfloat16) * 0.8)(B, Hq, T, D)), 'k_cache': _w((lambda *s: torch.randn(*s, dtype=torch.bfloat16) * 0.8)(B, Hkv, C, D)), 'v_cache': _w((lambda *s: torch.randn(*s, dtype=torch.bfloat16) * 0.05)(B, Hkv, C, D)), 'k_tree': _w((lambda *s: torch.randn(*s, dtype=torch.bfloat16) * 0.8)(B, Hkv, T, D)), 'v_tree': _w((lambda *s: torch.randn(*s, dtype=torch.bfloat16) * 0.05)(B, Hkv, T, D)), 'tree_mask': _w(tree_mask)}

def reference(q, k_cache, v_cache, k_tree, v_tree, tree_mask):
    B, Hq, T, D = q.shape
    Hkv, C = (k_cache.shape[1], k_cache.shape[2])
    rep = Hq // Hkv
    kc = (lambda x, n, axis: torch.repeat_interleave(x, n, dim=axis))(k_cache, rep, axis=1)
    vc = (lambda x, n, axis: torch.repeat_interleave(x, n, dim=axis))(v_cache, rep, axis=1)
    kt = (lambda x, n, axis: torch.repeat_interleave(x, n, dim=axis))(k_tree, rep, axis=1)
    vt = (lambda x, n, axis: torch.repeat_interleave(x, n, dim=axis))(v_tree, rep, axis=1)
    k = torch.concatenate([kc, kt], axis=2)
    v = torch.concatenate([vc, vt], axis=2)
    scale = D ** (-0.5)
    scores = torch.einsum('bhqd,bhkd->bhqk', q, k) * scale
    ctx_mask = torch.ones((B, 1, T, C), dtype=scores.dtype)
    tm = tree_mask[:, None, :, :].clone()
    full_mask = torch.concatenate([ctx_mask, tm], axis=-1)
    scores = scores + (1.0 - full_mask) * -1000000000.0
    p = _softmax(scores, axis=-1)
    return torch.einsum('bhqk,bhkd->bhqd', p, v)
```

```asm
; @launch grid=(256,1,1) block=(1024,1,1) lds=16656
.amdgcn_target "amdgcn-amd-amdhsa--gfx950"
.text
.globl standalone__tree_speculative_verify_tree_attention_over_candidate_token_tree__decode_kernel
.p2align 8
.type standalone__tree_speculative_verify_tree_attention_over_candidate_token_tree__decode_kernel,@function
standalone__tree_speculative_verify_tree_attention_over_candidate_token_tree__decode_kernel:
  s_cmp_ge_u32 s2, 256
  s_cbranch_scc1 L_end
  s_load_dwordx4 s[4:7], s[0:1], 0
  s_load_dwordx2 s[8:9], s[0:1], 16
  s_load_dwordx2 s[10:11], s[0:1], 64
  s_load_dwordx8 s[40:47], s[0:1], 24
  s_load_dwordx2 s[48:49], s[0:1], 56
  v_lshrrev_b32 v1, 6, v0
  v_and_b32 v2, 63, v0
  s_nop 0
  v_readfirstlane_b32 s30, v1
  s_lshr_b32 s28, s2, 3
  s_and_b32 s29, s2, 7
  s_mov_b32 s32, 0x3e0293ee
  v_and_b32 v3, 15, v2
  v_lshrrev_b32 v4, 4, v2
  v_lshlrev_b32 v5, 8, v3
  v_lshl_add_u32 v5, v4, 4, v5
  v_lshlrev_b32 v6, 4, v3
  v_lshl_add_u32 v6, v4, 10, v6
  v_and_b32 v7, 1, v2
  v_lshlrev_b32 v7, 8, v7
  v_lshl_add_u32 v7, v4, 4, v7
  s_waitcnt lgkmcnt(0)
  s_mov_b32 s12, s4
  s_and_b32 s13, s5, 0xffff
  s_mov_b32 s14, 0x4000
  s_mov_b32 s15, 0x00020000
  s_mov_b32 s16, s6
  s_and_b32 s17, s7, 0xffff
  s_mov_b32 s18, 0x8000000
  s_mov_b32 s19, 0x00020000
  s_mov_b32 s20, s8
  s_and_b32 s21, s9, 0xffff
  s_mov_b32 s22, 0x8000000
  s_mov_b32 s23, 0x00020000
  s_mov_b32 s24, s10
  s_and_b32 s25, s11, 0xffff
  s_mov_b32 s26, 0x1000000
  s_mov_b32 s27, 0x00020000
  s_mov_b32 s52, s40
  s_and_b32 s53, s41, 0xffff
  s_mov_b32 s54, 0x2000
  s_mov_b32 s55, 0x00020000
  s_mov_b32 s56, s42
  s_and_b32 s57, s43, 0xffff
  s_mov_b32 s58, 0x2000
  s_mov_b32 s59, 0x00020000
  s_mov_b32 s60, s44
  s_and_b32 s61, s45, 0xffff
  s_mov_b32 s62, 0x4
  s_mov_b32 s63, 0x00020000
  s_mov_b32 s64, s46
  s_and_b32 s65, s47, 0xffff
  s_mov_b32 s66, 0x4000
  s_mov_b32 s67, 0x00020000
  s_mov_b32 s68, s48
  s_and_b32 s69, s49, 0xffff
  s_mov_b32 s70, 0x100
  s_mov_b32 s71, 0x00020000
  s_lshl_b32 s31, s28, 22
  s_mul_i32 s33, s29, 524288
  s_add_u32 s31, s31, s33
  s_mul_i32 s33, s30, 4096
  s_add_u32 s31, s31, s33
  s_lshl_b32 s34, s28, 9
  buffer_load_dwordx4 v[8:11], v7, s[12:15], s34 offen offset:0
  buffer_load_dwordx4 v[12:15], v7, s[12:15], s34 offen offset:64
  buffer_load_dwordx4 v[16:19], v7, s[12:15], s34 offen offset:128
  buffer_load_dwordx4 v[20:23], v7, s[12:15], s34 offen offset:192
  s_add_u32 s33, s31, 0
  buffer_load_dwordx4 v[24:27], v5, s[16:19], s33 offen offset:0 nt
  buffer_load_dwordx4 v[28:31], v5, s[16:19], s33 offen offset:64 nt
  buffer_load_dwordx4 v[32:35], v5, s[16:19], s33 offen offset:128 nt
  buffer_load_dwordx4 v[36:39], v5, s[16:19], s33 offen offset:192 nt
  s_add_u32 s33, s31, 0
  buffer_load_dwordx4 v[56:59], v6, s[20:23], s33 offen offset:0 nt
  buffer_load_dwordx4 v[60:63], v6, s[20:23], s33 offen offset:256 nt
  buffer_load_dwordx4 v[64:67], v6, s[20:23], s33 offen offset:512 nt
  buffer_load_dwordx4 v[68:71], v6, s[20:23], s33 offen offset:768 nt
  s_add_u32 s33, s31, 65536
  buffer_load_dwordx4 v[40:43], v5, s[16:19], s33 offen offset:0 nt
  buffer_load_dwordx4 v[44:47], v5, s[16:19], s33 offen offset:64 nt
  buffer_load_dwordx4 v[48:51], v5, s[16:19], s33 offen offset:128 nt
  buffer_load_dwordx4 v[52:55], v5, s[16:19], s33 offen offset:192 nt
  s_add_u32 s33, s31, 65536
  buffer_load_dwordx4 v[72:75], v6, s[20:23], s33 offen offset:0 nt
  buffer_load_dwordx4 v[76:79], v6, s[20:23], s33 offen offset:256 nt
  buffer_load_dwordx4 v[80:83], v6, s[20:23], s33 offen offset:512 nt
  buffer_load_dwordx4 v[84:87], v6, s[20:23], s33 offen offset:768 nt
  v_mov_b32 v92, 0
  v_mov_b32 v93, 0
  v_mov_b32 v94, 0
  v_mov_b32 v95, 0
  v_mov_b32 v96, 0
  v_mov_b32 v97, 0
  v_mov_b32 v98, 0
  v_mov_b32 v99, 0
  v_mov_b32 v100, 0
  v_mov_b32 v101, 0
  v_mov_b32 v102, 0
  v_mov_b32 v103, 0
  v_mov_b32 v104, 0
  v_mov_b32 v105, 0
  v_mov_b32 v106, 0
  v_mov_b32 v107, 0
  v_mov_b32 v108, 0xf149f2ca
  v_mov_b32 v109, 0
  s_waitcnt vmcnt(12)
  v_mfma_f32_16x16x32_bf16 v[88:91], v[24:27], v[8:11], 0
  v_mfma_f32_16x16x32_bf16 v[88:91], v[28:31], v[12:15], v[88:91]
  v_mfma_f32_16x16x32_bf16 v[88:91], v[32:35], v[16:19], v[88:91]
  v_mfma_f32_16x16x32_bf16 v[88:91], v[36:39], v[20:23], v[88:91]
  s_add_u32 s33, s31, 131072
  buffer_load_dwordx4 v[24:27], v5, s[16:19], s33 offen offset:0 nt
  buffer_load_dwordx4 v[28:31], v5, s[16:19], s33 offen offset:64 nt
  buffer_load_dwordx4 v[32:35], v5, s[16:19], s33 offen offset:128 nt
  buffer_load_dwordx4 v[36:39], v5, s[16:19], s33 offen offset:192 nt
  s_nop 3
  s_nop 1
  v_max_f32 v112, v88, v89
  v_max3_f32 v112, v112, v90, v91
  v_max_f32 v112, v108, v112
  v_sub_f32 v113, v108, v112
  v_mul_f32 v113, s32, v113
  v_exp_f32 v110, v113
  v_mov_b32 v108, v112
  v_mul_f32 v113, s32, v112
  v_fma_f32 v114, v88, s32, -v113
  v_fma_f32 v115, v89, s32, -v113
  v_fma_f32 v116, v90, s32, -v113
  v_fma_f32 v117, v91, s32, -v113
  v_exp_f32 v114, v114
  v_exp_f32 v115, v115
  v_exp_f32 v116, v116
  v_exp_f32 v117, v117
  v_mov_b32_dpp v111, v110 quad_perm:[1,0,3,2] row_mask:0xf bank_mask:0xf
  v_mul_f32 v109, v109, v110
  v_mov_b32_dpp v118, v114 quad_perm:[1,0,3,2] row_mask:0xf bank_mask:0xf
  v_mov_b32_dpp v119, v115 quad_perm:[1,0,3,2] row_mask:0xf bank_mask:0xf
  v_mov_b32_dpp v120, v116 quad_perm:[1,0,3,2] row_mask:0xf bank_mask:0xf
  v_mov_b32_dpp v121, v117 quad_perm:[1,0,3,2] row_mask:0xf bank_mask:0xf
  v_add_f32 v112, v114, v115
  v_add_f32 v113, v116, v117
  v_add_f32 v112, v112, v113
  v_add_f32 v109, v109, v112
  v_mul_f32 v92, v92, v110
  v_mul_f32 v93, v93, v110
  v_mul_f32 v94, v94, v110
  v_mul_f32 v95, v95, v110
  v_mul_f32 v96, v96, v110
  v_mul_f32 v97, v97, v110
  v_mul_f32 v98, v98, v110
  v_mul_f32 v99, v99, v110
  v_mul_f32 v100, v100, v111
  v_mul_f32 v101, v101, v111
  v_mul_f32 v102, v102, v111
  v_mul_f32 v103, v103, v111
  v_mul_f32 v104, v104, v111
  v_mul_f32 v105, v105, v111
  v_mul_f32 v106, v106, v111
  v_mul_f32 v107, v107, v111
  s_waitcnt vmcnt(12)
  v_lshlrev_b32 v122, 16, v56
  v_and_b32 v123, 0xffff0000, v56
  v_fmac_f32 v92, v114, v122
  v_fmac_f32 v93, v114, v123
  v_fmac_f32 v100, v118, v122
  v_fmac_f32 v101, v118, v123
  v_lshlrev_b32 v124, 16, v57
  v_and_b32 v125, 0xffff0000, v57
  v_fmac_f32 v94, v114, v124
  v_fmac_f32 v95, v114, v125
  v_fmac_f32 v102, v118, v124
  v_fmac_f32 v103, v118, v125
  v_lshlrev_b32 v122, 16, v58
  v_and_b32 v123, 0xffff0000, v58
  v_fmac_f32 v96, v114, v122
  v_fmac_f32 v97, v114, v123
  v_fmac_f32 v104, v118, v122
  v_fmac_f32 v105, v118, v123
  v_lshlrev_b32 v124, 16, v59
  v_and_b32 v125, 0xffff0000, v59
  v_fmac_f32 v98, v114, v124
  v_fmac_f32 v99, v114, v125
  v_fmac_f32 v106, v118, v124
  v_fmac_f32 v107, v118, v125
  v_lshlrev_b32 v122, 16, v60
  v_and_b32 v123, 0xffff0000, v60
  v_fmac_f32 v92, v115, v122
  v_fmac_f32 v93, v115, v123
  v_fmac_f32 v100, v119, v122
  v_fmac_f32 v101, v119, v123
  v_lshlrev_b32 v124, 16, v61
  v_and_b32 v125, 0xffff0000, v61
  v_fmac_f32 v94, v115, v124
  v_fmac_f32 v95, v115, v125
  v_fmac_f32 v102, v119, v124
  v_fmac_f32 v103, v119, v125
  v_lshlrev_b32 v122, 16, v62
  v_and_b32 v123, 0xffff0000, v62
  v_fmac_f32 v96, v115, v122
  v_fmac_f32 v97, v115, v123
  v_fmac_f32 v104, v119, v122
  v_fmac_f32 v105, v119, v123
  v_lshlrev_b32 v124, 16, v63
  v_and_b32 v125, 0xffff0000, v63
  v_fmac_f32 v98, v115, v124
  v_fmac_f32 v99, v115, v125
  v_fmac_f32 v106, v119, v124
  v_fmac_f32 v107, v119, v125
  v_lshlrev_b32 v122, 16, v64
  v_and_b32 v123, 0xffff0000, v64
  v_fmac_f32 v92, v116, v122
  v_fmac_f32 v93, v116, v123
  v_fmac_f32 v100, v120, v122
  v_fmac_f32 v101, v120, v123
  v_lshlrev_b32 v124, 16, v65
  v_and_b32 v125, 0xffff0000, v65
  v_fmac_f32 v94, v116, v124
  v_fmac_f32 v95, v116, v125
  v_fmac_f32 v102, v120, v124
  v_fmac_f32 v103, v120, v125
  v_lshlrev_b32 v122, 16, v66
  v_and_b32 v123, 0xffff0000, v66
  v_fmac_f32 v96, v116, v122
  v_fmac_f32 v97, v116, v123
  v_fmac_f32 v104, v120, v122
  v_fmac_f32 v105, v120, v123
  v_lshlrev_b32 v124, 16, v67
  v_and_b32 v125, 0xffff0000, v67
  v_fmac_f32 v98, v116, v124
  v_fmac_f32 v99, v116, v125
  v_fmac_f32 v106, v120, v124
  v_fmac_f32 v107, v120, v125
  v_lshlrev_b32 v122, 16, v68
  v_and_b32 v123, 0xffff0000, v68
  v_fmac_f32 v92, v117, v122
  v_fmac_f32 v93, v117, v123
  v_fmac_f32 v100, v121, v122
  v_fmac_f32 v101, v121, v123
  v_lshlrev_b32 v124, 16, v69
  v_and_b32 v125, 0xffff0000, v69
  v_fmac_f32 v94, v117, v124
  v_fmac_f32 v95, v117, v125
  v_fmac_f32 v102, v121, v124
  v_fmac_f32 v103, v121, v125
  v_lshlrev_b32 v122, 16, v70
  v_and_b32 v123, 0xffff0000, v70
  v_fmac_f32 v96, v117, v122
  v_fmac_f32 v97, v117, v123
  v_fmac_f32 v104, v121, v122
  v_fmac_f32 v105, v121, v123
  v_lshlrev_b32 v124, 16, v71
  v_and_b32 v125, 0xffff0000, v71
  v_fmac_f32 v98, v117, v124
  v_fmac_f32 v99, v117, v125
  v_fmac_f32 v106, v121, v124
  v_fmac_f32 v107, v121, v125
  s_add_u32 s33, s31, 131072
  buffer_load_dwordx4 v[56:59], v6, s[20:23], s33 offen offset:0 nt
  buffer_load_dwordx4 v[60:63], v6, s[20:23], s33 offen offset:256 nt
  buffer_load_dwordx4 v[64:67], v6, s[20:23], s33 offen offset:512 nt
  buffer_load_dwordx4 v[68:71], v6, s[20:23], s33 offen offset:768 nt
  s_waitcnt vmcnt(12)
  v_mfma_f32_16x16x32_bf16 v[88:91], v[40:43], v[8:11], 0
  v_mfma_f32_16x16x32_bf16 v[88:91], v[44:47], v[12:15], v[88:91]
  v_mfma_f32_16x16x32_bf16 v[88:91], v[48:51], v[16:19], v[88:91]
  v_mfma_f32_16x16x32_bf16 v[88:91], v[52:55], v[20:23], v[88:91]
  s_add_u32 s33, s31, 196608
  buffer_load_dwordx4 v[40:43], v5, s[16:19], s33 offen offset:0 nt
  buffer_load_dwordx4 v[44:47], v5, s[16:19], s33 offen offset:64 nt
  buffer_load_dwordx4 v[48:51], v5, s[16:19], s33 offen offset:128 nt
  buffer_load_dwordx4 v[52:55], v5, s[16:19], s33 offen offset:192 nt
  s_nop 3
  s_nop 1
  v_max_f32 v112, v88, v89
  v_max3_f32 v112, v112, v90, v91
  v_max_f32 v112, v108, v112
  v_sub_f32 v113, v108, v112
  v_mul_f32 v113, s32, v113
  v_exp_f32 v110, v113
  v_mov_b32 v108, v112
  v_mul_f32 v113, s32, v112
  v_fma_f32 v114, v88, s32, -v113
  v_fma_f32 v115, v89, s32, -v113
  v_fma_f32 v116, v90, s32, -v113
  v_fma_f32 v117, v91, s32, -v113
  v_exp_f32 v114, v114
  v_exp_f32 v115, v115
  v_exp_f32 v116, v116
  v_exp_f32 v117, v117
  v_mov_b32_dpp v111, v110 quad_perm:[1,0,3,2] row_mask:0xf bank_mask:0xf
  v_mul_f32 v109, v109, v110
  v_mov_b32_dpp v118, v114 quad_perm:[1,0,3,2] row_mask:0xf bank_mask:0xf
  v_mov_b32_dpp v119, v115 quad_perm:[1,0,3,2] row_mask:0xf bank_mask:0xf
  v_mov_b32_dpp v120, v116 quad_perm:[1,0,3,2] row_mask:0xf bank_mask:0xf
  v_mov_b32_dpp v121, v117 quad_perm:[1,0,3,2] row_mask:0xf bank_mask:0xf
  v_add_f32 v112, v114, v115
  v_add_f32 v113, v116, v117
  v_add_f32 v112, v112, v113
  v_add_f32 v109, v109, v112
  v_mul_f32 v92, v92, v110
  v_mul_f32 v93, v93, v110
  v_mul_f32 v94, v94, v110
  v_mul_f32 v95, v95, v110
  v_mul_f32 v96, v96, v110
  v_mul_f32 v97, v97, v110
  v_mul_f32 v98, v98, v110
  v_mul_f32 v99, v99, v110
  v_mul_f32 v100, v100, v111
  v_mul_f32 v101, v101, v111
  v_mul_f32 v102, v102, v111
  v_mul_f32 v103, v103, v111
  v_mul_f32 v104, v104, v111
  v_mul_f32 v105, v105, v111
  v_mul_f32 v106, v106, v111
  v_mul_f32 v107, v107, v111
  s_waitcnt vmcnt(12)
  v_lshlrev_b32 v122, 16, v72
  v_and_b32 v123, 0xffff0000, v72
  v_fmac_f32 v92, v114, v122
  v_fmac_f32 v93, v114, v123
  v_fmac_f32 v100, v118, v122
  v_fmac_f32 v101, v118, v123
  v_lshlrev_b32 v124, 16, v73
  v_and_b32 v125, 0xffff0000, v73
  v_fmac_f32 v94, v114, v124
  v_fmac_f32 v95, v114, v125
  v_fmac_f32 v102, v118, v124
  v_fmac_f32 v103, v118, v125
  v_lshlrev_b32 v122, 16, v74
  v_and_b32 v123, 0xffff0000, v74
  v_fmac_f32 v96, v114, v122
  v_fmac_f32 v97, v114, v123
  v_fmac_f32 v104, v118, v122
  v_fmac_f32 v105, v118, v123
  v_lshlrev_b32 v124, 16, v75
  v_and_b32 v125, 0xffff0000, v75
  v_fmac_f32 v98, v114, v124
  v_fmac_f32 v99, v114, v125
  v_fmac_f32 v106, v118, v124
  v_fmac_f32 v107, v118, v125
  v_lshlrev_b32 v122, 16, v76
  v_and_b32 v123, 0xffff0000, v76
  v_fmac_f32 v92, v115, v122
  v_fmac_f32 v93, v115, v123
  v_fmac_f32 v100, v119, v122
  v_fmac_f32 v101, v119, v123
  v_lshlrev_b32 v124, 16, v77
  v_and_b32 v125, 0xffff0000, v77
  v_fmac_f32 v94, v115, v124
  v_fmac_f32 v95, v115, v125
  v_fmac_f32 v102, v119, v124
  v_fmac_f32 v103, v119, v125
  v_lshlrev_b32 v122, 16, v78
  v_and_b32 v123, 0xffff0000, v78
  v_fmac_f32 v96, v115, v122
  v_fmac_f32 v97, v115, v123
  v_fmac_f32 v104, v119, v122
  v_fmac_f32 v105, v119, v123
  v_lshlrev_b32 v124, 16, v79
  v_and_b32 v125, 0xffff0000, v79
  v_fmac_f32 v98, v115, v124
  v_fmac_f32 v99, v115, v125
  v_fmac_f32 v106, v119, v124
  v_fmac_f32 v107, v119, v125
  v_lshlrev_b32 v122, 16, v80
  v_and_b32 v123, 0xffff0000, v80
  v_fmac_f32 v92, v116, v122
  v_fmac_f32 v93, v116, v123
  v_fmac_f32 v100, v120, v122
  v_fmac_f32 v101, v120, v123
  v_lshlrev_b32 v124, 16, v81
  v_and_b32 v125, 0xffff0000, v81
  v_fmac_f32 v94, v116, v124
  v_fmac_f32 v95, v116, v125
  v_fmac_f32 v102, v120, v124
  v_fmac_f32 v103, v120, v125
  v_lshlrev_b32 v122, 16, v82
  v_and_b32 v123, 0xffff0000, v82
  v_fmac_f32 v96, v116, v122
  v_fmac_f32 v97, v116, v123
  v_fmac_f32 v104, v120, v122
  v_fmac_f32 v105, v120, v123
  v_lshlrev_b32 v124, 16, v83
  v_and_b32 v125, 0xffff0000, v83
  v_fmac_f32 v98, v116, v124
  v_fmac_f32 v99, v116, v125
  v_fmac_f32 v106, v120, v124
  v_fmac_f32 v107, v120, v125
  v_lshlrev_b32 v122, 16, v84
  v_and_b32 v123, 0xffff0000, v84
  v_fmac_f32 v92, v117, v122
  v_fmac_f32 v93, v117, v123
  v_fmac_f32 v100, v121, v122
  v_fmac_f32 v101, v121, v123
  v_lshlrev_b32 v124, 16, v85
  v_and_b32 v125, 0xffff0000, v85
  v_fmac_f32 v94, v117, v124
  v_fmac_f32 v95, v117, v125
  v_fmac_f32 v102, v121, v124
  v_fmac_f32 v103, v121, v125
  v_lshlrev_b32 v122, 16, v86
  v_and_b32 v123, 0xffff0000, v86
  v_fmac_f32 v96, v117, v122
  v_fmac_f32 v97, v117, v123
  v_fmac_f32 v104, v121, v122
  v_fmac_f32 v105, v121, v123
  v_lshlrev_b32 v124, 16, v87
  v_and_b32 v125, 0xffff0000, v87
  v_fmac_f32 v98, v117, v124
  v_fmac_f32 v99, v117, v125
  v_fmac_f32 v106, v121, v124
  v_fmac_f32 v107, v121, v125
  s_add_u32 s33, s31, 196608
  buffer_load_dwordx4 v[72:75], v6, s[20:23], s33 offen offset:0 nt
  buffer_load_dwordx4 v[76:79], v6, s[20:23], s33 offen offset:256 nt
  buffer_load_dwordx4 v[80:83], v6, s[20:23], s33 offen offset:512 nt
  buffer_load_dwordx4 v[84:87], v6, s[20:23], s33 offen offset:768 nt
  s_waitcnt vmcnt(12)
  v_mfma_f32_16x16x32_bf16 v[88:91], v[24:27], v[8:11], 0
  v_mfma_f32_16x16x32_bf16 v[88:91], v[28:31], v[12:15], v[88:91]
  v_mfma_f32_16x16x32_bf16 v[88:91], v[32:35], v[16:19], v[88:91]
  v_mfma_f32_16x16x32_bf16 v[88:91], v[36:39], v[20:23], v[88:91]
  s_add_u32 s33, s31, 262144
  buffer_load_dwordx4 v[24:27], v5, s[16:19], s33 offen offset:0 nt
  buffer_load_dwordx4 v[28:31], v5, s[16:19], s33 offen offset:64 nt
  buffer_load_dwordx4 v[32:35], v5, s[16:19], s33 offen offset:128 nt
  buffer_load_dwordx4 v[36:39], v5, s[16:19], s33 offen offset:192 nt
  s_nop 3
  s_nop 1
  v_max_f32 v112, v88, v89
  v_max3_f32 v112, v112, v90, v91
  v_max_f32 v112, v108, v112
  v_sub_f32 v113, v108, v112
  v_mul_f32 v113, s32, v113
  v_exp_f32 v110, v113
  v_mov_b32 v108, v112
  v_mul_f32 v113, s32, v112
  v_fma_f32 v114, v88, s32, -v113
  v_fma_f32 v115, v89, s32, -v113
  v_fma_f32 v116, v90, s32, -v113
  v_fma_f32 v117, v91, s32, -v113
  v_exp_f32 v114, v114
  v_exp_f32 v115, v115
  v_exp_f32 v116, v116
  v_exp_f32 v117, v117
  v_mov_b32_dpp v111, v110 quad_perm:[1,0,3,2] row_mask:0xf bank_mask:0xf
  v_mul_f32 v109, v109, v110
  v_mov_b32_dpp v118, v114 quad_perm:[1,0,3,2] row_mask:0xf bank_mask:0xf
  v_mov_b32_dpp v119, v115 quad_perm:[1,0,3,2] row_mask:0xf bank_mask:0xf
  v_mov_b32_dpp v120, v116 quad_perm:[1,0,3,2] row_mask:0xf bank_mask:0xf
  v_mov_b32_dpp v121, v117 quad_perm:[1,0,3,2] row_mask:0xf bank_mask:0xf
  v_add_f32 v112, v114, v115
  v_add_f32 v113, v116, v117
  v_add_f32 v112, v112, v113
  v_add_f32 v109, v109, v112
  v_mul_f32 v92, v92, v110
  v_mul_f32 v93, v93, v110
  v_mul_f32 v94, v94, v110
  v_mul_f32 v95, v95, v110
  v_mul_f32 v96, v96, v110
  v_mul_f32 v97, v97, v110
  v_mul_f32 v98, v98, v110
  v_mul_f32 v99, v99, v110
  v_mul_f32 v100, v100, v111
  v_mul_f32 v101, v101, v111
  v_mul_f32 v102, v102, v111
  v_mul_f32 v103, v103, v111
  v_mul_f32 v104, v104, v111
  v_mul_f32 v105, v105, v111
  v_mul_f32 v106, v106, v111
  v_mul_f32 v107, v107, v111
  s_waitcnt vmcnt(12)
  v_lshlrev_b32 v122, 16, v56
  v_and_b32 v123, 0xffff0000, v56
  v_fmac_f32 v92, v114, v122
  v_fmac_f32 v93, v114, v123
  v_fmac_f32 v100, v118, v122
  v_fmac_f32 v101, v118, v123
  v_lshlrev_b32 v124, 16, v57
  v_and_b32 v125, 0xffff0000, v57
  v_fmac_f32 v94, v114, v124
  v_fmac_f32 v95, v114, v125
  v_fmac_f32 v102, v118, v124
  v_fmac_f32 v103, v118, v125
  v_lshlrev_b32 v122, 16, v58
  v_and_b32 v123, 0xffff0000, v58
  v_fmac_f32 v96, v114, v122
  v_fmac_f32 v97, v114, v123
  v_fmac_f32 v104, v118, v122
  v_fmac_f32 v105, v118, v123
  v_lshlrev_b32 v124, 16, v59
  v_and_b32 v125, 0xffff0000, v59
  v_fmac_f32 v98, v114, v124
  v_fmac_f32 v99, v114, v125
  v_fmac_f32 v106, v118, v124
  v_fmac_f32 v107, v118, v125
  v_lshlrev_b32 v122, 16, v60
  v_and_b32 v123, 0xffff0000, v60
  v_fmac_f32 v92, v115, v122
  v_fmac_f32 v93, v115, v123
  v_fmac_f32 v100, v119, v122
  v_fmac_f32 v101, v119, v123
  v_lshlrev_b32 v124, 16, v61
  v_and_b32 v125, 0xffff0000, v61
  v_fmac_f32 v94, v115, v124
  v_fmac_f32 v95, v115, v125
  v_fmac_f32 v102, v119, v124
  v_fmac_f32 v103, v119, v125
  v_lshlrev_b32 v122, 16, v62
  v_and_b32 v123, 0xffff0000, v62
  v_fmac_f32 v96, v115, v122
  v_fmac_f32 v97, v115, v123
  v_fmac_f32 v104, v119, v122
  v_fmac_f32 v105, v119, v123
  v_lshlrev_b32 v124, 16, v63
  v_and_b32 v125, 0xffff0000, v63
  v_fmac_f32 v98, v115, v124
  v_fmac_f32 v99, v115, v125
  v_fmac_f32 v106, v119, v124
  v_fmac_f32 v107, v119, v125
  v_lshlrev_b32 v122, 16, v64
  v_and_b32 v123, 0xffff0000, v64
  v_fmac_f32 v92, v116, v122
  v_fmac_f32 v93, v116, v123
  v_fmac_f32 v100, v120, v122
  v_fmac_f32 v101, v120, v123
  v_lshlrev_b32 v124, 16, v65
  v_and_b32 v125, 0xffff0000, v65
  v_fmac_f32 v94, v116, v124
  v_fmac_f32 v95, v116, v125
  v_fmac_f32 v102, v120, v124
  v_fmac_f32 v103, v120, v125
  v_lshlrev_b32 v122, 16, v66
  v_and_b32 v123, 0xffff0000, v66
  v_fmac_f32 v96, v116, v122
  v_fmac_f32 v97, v116, v123
  v_fmac_f32 v104, v120, v122
  v_fmac_f32 v105, v120, v123
  v_lshlrev_b32 v124, 16, v67
  v_and_b32 v125, 0xffff0000, v67
  v_fmac_f32 v98, v116, v124
  v_fmac_f32 v99, v116, v125
  v_fmac_f32 v106, v120, v124
  v_fmac_f32 v107, v120, v125
  v_lshlrev_b32 v122, 16, v68
  v_and_b32 v123, 0xffff0000, v68
  v_fmac_f32 v92, v117, v122
  v_fmac_f32 v93, v117, v123
  v_fmac_f32 v100, v121, v122
  v_fmac_f32 v101, v121, v123
  v_lshlrev_b32 v124, 16, v69
  v_and_b32 v125, 0xffff0000, v69
  v_fmac_f32 v94, v117, v124
  v_fmac_f32 v95, v117, v125
  v_fmac_f32 v102, v121, v124
  v_fmac_f32 v103, v121, v125
  v_lshlrev_b32 v122, 16, v70
  v_and_b32 v123, 0xffff0000, v70
  v_fmac_f32 v96, v117, v122
  v_fmac_f32 v97, v117, v123
  v_fmac_f32 v104, v121, v122
  v_fmac_f32 v105, v121, v123
  v_lshlrev_b32 v124, 16, v71
  v_and_b32 v125, 0xffff0000, v71
  v_fmac_f32 v98, v117, v124
  v_fmac_f32 v99, v117, v125
  v_fmac_f32 v106, v121, v124
  v_fmac_f32 v107, v121, v125
  s_add_u32 s33, s31, 262144
  buffer_load_dwordx4 v[56:59], v6, s[20:23], s33 offen offset:0 nt
  buffer_load_dwordx4 v[60:63], v6, s[20:23], s33 offen offset:256 nt
  buffer_load_dwordx4 v[64:67], v6, s[20:23], s33 offen offset:512 nt
  buffer_load_dwordx4 v[68:71], v6, s[20:23], s33 offen offset:768 nt
  s_waitcnt vmcnt(12)
  v_mfma_f32_16x16x32_bf16 v[88:91], v[40:43], v[8:11], 0
  v_mfma_f32_16x16x32_bf16 v[88:91], v[44:47], v[12:15], v[88:91]
  v_mfma_f32_16x16x32_bf16 v[88:91], v[48:51], v[16:19], v[88:91]
  v_mfma_f32_16x16x32_bf16 v[88:91], v[52:55], v[20:23], v[88:91]
  s_add_u32 s33, s31, 327680
  buffer_load_dwordx4 v[40:43], v5, s[16:19], s33 offen offset:0 nt
  buffer_load_dwordx4 v[44:47], v5, s[16:19], s33 offen offset:64 nt
  buffer_load_dwordx4 v[48:51], v5, s[16:19], s33 offen offset:128 nt
  buffer_load_dwordx4 v[52:55], v5, s[16:19], s33 offen offset:192 nt
  s_nop 3
  s_nop 1
  v_max_f32 v112, v88, v89
  v_max3_f32 v112, v112, v90, v91
  v_max_f32 v112, v108, v112
  v_sub_f32 v113, v108, v112
  v_mul_f32 v113, s32, v113
  v_exp_f32 v110, v113
  v_mov_b32 v108, v112
  v_mul_f32 v113, s32, v112
  v_fma_f32 v114, v88, s32, -v113
  v_fma_f32 v115, v89, s32, -v113
  v_fma_f32 v116, v90, s32, -v113
  v_fma_f32 v117, v91, s32, -v113
  v_exp_f32 v114, v114
  v_exp_f32 v115, v115
  v_exp_f32 v116, v116
  v_exp_f32 v117, v117
  v_mov_b32_dpp v111, v110 quad_perm:[1,0,3,2] row_mask:0xf bank_mask:0xf
  v_mul_f32 v109, v109, v110
  v_mov_b32_dpp v118, v114 quad_perm:[1,0,3,2] row_mask:0xf bank_mask:0xf
  v_mov_b32_dpp v119, v115 quad_perm:[1,0,3,2] row_mask:0xf bank_mask:0xf
  v_mov_b32_dpp v120, v116 quad_perm:[1,0,3,2] row_mask:0xf bank_mask:0xf
  v_mov_b32_dpp v121, v117 quad_perm:[1,0,3,2] row_mask:0xf bank_mask:0xf
  v_add_f32 v112, v114, v115
  v_add_f32 v113, v116, v117
  v_add_f32 v112, v112, v113
  v_add_f32 v109, v109, v112
  v_mul_f32 v92, v92, v110
  v_mul_f32 v93, v93, v110
  v_mul_f32 v94, v94, v110
  v_mul_f32 v95, v95, v110
  v_mul_f32 v96, v96, v110
  v_mul_f32 v97, v97, v110
  v_mul_f32 v98, v98, v110
  v_mul_f32 v99, v99, v110
  v_mul_f32 v100, v100, v111
  v_mul_f32 v101, v101, v111
  v_mul_f32 v102, v102, v111
  v_mul_f32 v103, v103, v111
  v_mul_f32 v104, v104, v111
  v_mul_f32 v105, v105, v111
  v_mul_f32 v106, v106, v111
  v_mul_f32 v107, v107, v111
  s_waitcnt vmcnt(12)
  v_lshlrev_b32 v122, 16, v72
  v_and_b32 v123, 0xffff0000, v72
  v_fmac_f32 v92, v114, v122
  v_fmac_f32 v93, v114, v123
  v_fmac_f32 v100, v118, v122
  v_fmac_f32 v101, v118, v123
  v_lshlrev_b32 v124, 16, v73
  v_and_b32 v125, 0xffff0000, v73
  v_fmac_f32 v94, v114, v124
  v_fmac_f32 v95, v114, v125
  v_fmac_f32 v102, v118, v124
  v_fmac_f32 v103, v118, v125
  v_lshlrev_b32 v122, 16, v74
  v_and_b32 v123, 0xffff0000, v74
  v_fmac_f32 v96, v114, v122
  v_fmac_f32 v97, v114, v123
  v_fmac_f32 v104, v118, v122
  v_fmac_f32 v105, v118, v123
  v_lshlrev_b32 v124, 16, v75
  v_and_b32 v125, 0xffff0000, v75
  v_fmac_f32 v98, v114, v124
  v_fmac_f32 v99, v114, v125
  v_fmac_f32 v106, v118, v124
  v_fmac_f32 v107, v118, v125
  v_lshlrev_b32 v122, 16, v76
  v_and_b32 v123, 0xffff0000, v76
  v_fmac_f32 v92, v115, v122
  v_fmac_f32 v93, v115, v123
  v_fmac_f32 v100, v119, v122
  v_fmac_f32 v101, v119, v123
  v_lshlrev_b32 v124, 16, v77
  v_and_b32 v125, 0xffff0000, v77
  v_fmac_f32 v94, v115, v124
  v_fmac_f32 v95, v115, v125
  v_fmac_f32 v102, v119, v124
  v_fmac_f32 v103, v119, v125
  v_lshlrev_b32 v122, 16, v78
  v_and_b32 v123, 0xffff0000, v78
  v_fmac_f32 v96, v115, v122
  v_fmac_f32 v97, v115, v123
  v_fmac_f32 v104, v119, v122
  v_fmac_f32 v105, v119, v123
  v_lshlrev_b32 v124, 16, v79
  v_and_b32 v125, 0xffff0000, v79
  v_fmac_f32 v98, v115, v124
  v_fmac_f32 v99, v115, v125
  v_fmac_f32 v106, v119, v124
  v_fmac_f32 v107, v119, v125
  v_lshlrev_b32 v122, 16, v80
  v_and_b32 v123, 0xffff0000, v80
  v_fmac_f32 v92, v116, v122
  v_fmac_f32 v93, v116, v123
  v_fmac_f32 v100, v120, v122
  v_fmac_f32 v101, v120, v123
  v_lshlrev_b32 v124, 16, v81
  v_and_b32 v125, 0xffff0000, v81
  v_fmac_f32 v94, v116, v124
  v_fmac_f32 v95, v116, v125
  v_fmac_f32 v102, v120, v124
  v_fmac_f32 v103, v120, v125
  v_lshlrev_b32 v122, 16, v82
  v_and_b32 v123, 0xffff0000, v82
  v_fmac_f32 v96, v116, v122
  v_fmac_f32 v97, v116, v123
  v_fmac_f32 v104, v120, v122
  v_fmac_f32 v105, v120, v123
  v_lshlrev_b32 v124, 16, v83
  v_and_b32 v125, 0xffff0000, v83
  v_fmac_f32 v98, v116, v124
  v_fmac_f32 v99, v116, v125
  v_fmac_f32 v106, v120, v124
  v_fmac_f32 v107, v120, v125
  v_lshlrev_b32 v122, 16, v84
  v_and_b32 v123, 0xffff0000, v84
  v_fmac_f32 v92, v117, v122
  v_fmac_f32 v93, v117, v123
  v_fmac_f32 v100, v121, v122
  v_fmac_f32 v101, v121, v123
  v_lshlrev_b32 v124, 16, v85
  v_and_b32 v125, 0xffff0000, v85
  v_fmac_f32 v94, v117, v124
  v_fmac_f32 v95, v117, v125
  v_fmac_f32 v102, v121, v124
  v_fmac_f32 v103, v121, v125
  v_lshlrev_b32 v122, 16, v86
  v_and_b32 v123, 0xffff0000, v86
  v_fmac_f32 v96, v117, v122
  v_fmac_f32 v97, v117, v123
  v_fmac_f32 v104, v121, v122
  v_fmac_f32 v105, v121, v123
  v_lshlrev_b32 v124, 16, v87
  v_and_b32 v125, 0xffff0000, v87
  v_fmac_f32 v98, v117, v124
  v_fmac_f32 v99, v117, v125
  v_fmac_f32 v106, v121, v124
  v_fmac_f32 v107, v121, v125
  s_add_u32 s33, s31, 327680
  buffer_load_dwordx4 v[72:75], v6, s[20:23], s33 offen offset:0 nt
  buffer_load_dwordx4 v[76:79], v6, s[20:23], s33 offen offset:256 nt
  buffer_load_dwordx4 v[80:83], v6, s[20:23], s33 offen offset:512 nt
  buffer_load_dwordx4 v[84:87], v6, s[20:23], s33 offen offset:768 nt
  s_waitcnt vmcnt(12)
  v_mfma_f32_16x16x32_bf16 v[88:91], v[24:27], v[8:11], 0
  v_mfma_f32_16x16x32_bf16 v[88:91], v[28:31], v[12:15], v[88:91]
  v_mfma_f32_16x16x32_bf16 v[88:91], v[32:35], v[16:19], v[88:91]
  v_mfma_f32_16x16x32_bf16 v[88:91], v[36:39], v[20:23], v[88:91]
  s_add_u32 s33, s31, 393216
  buffer_load_dwordx4 v[24:27], v5, s[16:19], s33 offen offset:0 nt
  buffer_load_dwordx4 v[28:31], v5, s[16:19], s33 offen offset:64 nt
  buffer_load_dwordx4 v[32:35], v5, s[16:19], s33 offen offset:128 nt
  buffer_load_dwordx4 v[36:39], v5, s[16:19], s33 offen offset:192 nt
  s_nop 3
  s_nop 1
  v_max_f32 v112, v88, v89
  v_max3_f32 v112, v112, v90, v91
  v_max_f32 v112, v108, v112
  v_sub_f32 v113, v108, v112
  v_mul_f32 v113, s32, v113
  v_exp_f32 v110, v113
  v_mov_b32 v108, v112
  v_mul_f32 v113, s32, v112
  v_fma_f32 v114, v88, s32, -v113
  v_fma_f32 v115, v89, s32, -v113
  v_fma_f32 v116, v90, s32, -v113
  v_fma_f32 v117, v91, s32, -v113
  v_exp_f32 v114, v114
  v_exp_f32 v115, v115
  v_exp_f32 v116, v116
  v_exp_f32 v117, v117
  v_mov_b32_dpp v111, v110 quad_perm:[1,0,3,2] row_mask:0xf bank_mask:0xf
  v_mul_f32 v109, v109, v110
  v_mov_b32_dpp v118, v114 quad_perm:[1,0,3,2] row_mask:0xf bank_mask:0xf
  v_mov_b32_dpp v119, v115 quad_perm:[1,0,3,2] row_mask:0xf bank_mask:0xf
  v_mov_b32_dpp v120, v116 quad_perm:[1,0,3,2] row_mask:0xf bank_mask:0xf
  v_mov_b32_dpp v121, v117 quad_perm:[1,0,3,2] row_mask:0xf bank_mask:0xf
  v_add_f32 v112, v114, v115
  v_add_f32 v113, v116, v117
  v_add_f32 v112, v112, v113
  v_add_f32 v109, v109, v112
  v_mul_f32 v92, v92, v110
  v_mul_f32 v93, v93, v110
  v_mul_f32 v94, v94, v110
  v_mul_f32 v95, v95, v110
  v_mul_f32 v96, v96, v110
  v_mul_f32 v97, v97, v110
  v_mul_f32 v98, v98, v110
  v_mul_f32 v99, v99, v110
  v_mul_f32 v100, v100, v111
  v_mul_f32 v101, v101, v111
  v_mul_f32 v102, v102, v111
  v_mul_f32 v103, v103, v111
  v_mul_f32 v104, v104, v111
  v_mul_f32 v105, v105, v111
  v_mul_f32 v106, v106, v111
  v_mul_f32 v107, v107, v111
  s_waitcnt vmcnt(12)
  v_lshlrev_b32 v122, 16, v56
  v_and_b32 v123, 0xffff0000, v56
  v_fmac_f32 v92, v114, v122
  v_fmac_f32 v93, v114, v123
  v_fmac_f32 v100, v118, v122
  v_fmac_f32 v101, v118, v123
  v_lshlrev_b32 v124, 16, v57
  v_and_b32 v125, 0xffff0000, v57
  v_fmac_f32 v94, v114, v124
  v_fmac_f32 v95, v114, v125
  v_fmac_f32 v102, v118, v124
  v_fmac_f32 v103, v118, v125
  v_lshlrev_b32 v122, 16, v58
  v_and_b32 v123, 0xffff0000, v58
  v_fmac_f32 v96, v114, v122
  v_fmac_f32 v97, v114, v123
  v_fmac_f32 v104, v118, v122
  v_fmac_f32 v105, v118, v123
  v_lshlrev_b32 v124, 16, v59
  v_and_b32 v125, 0xffff0000, v59
  v_fmac_f32 v98, v114, v124
  v_fmac_f32 v99, v114, v125
  v_fmac_f32 v106, v118, v124
  v_fmac_f32 v107, v118, v125
  v_lshlrev_b32 v122, 16, v60
  v_and_b32 v123, 0xffff0000, v60
  v_fmac_f32 v92, v115, v122
  v_fmac_f32 v93, v115, v123
  v_fmac_f32 v100, v119, v122
  v_fmac_f32 v101, v119, v123
  v_lshlrev_b32 v124, 16, v61
  v_and_b32 v125, 0xffff0000, v61
  v_fmac_f32 v94, v115, v124
  v_fmac_f32 v95, v115, v125
  v_fmac_f32 v102, v119, v124
  v_fmac_f32 v103, v119, v125
  v_lshlrev_b32 v122, 16, v62
  v_and_b32 v123, 0xffff0000, v62
  v_fmac_f32 v96, v115, v122
  v_fmac_f32 v97, v115, v123
  v_fmac_f32 v104, v119, v122
  v_fmac_f32 v105, v119, v123
  v_lshlrev_b32 v124, 16, v63
  v_and_b32 v125, 0xffff0000, v63
  v_fmac_f32 v98, v115, v124
  v_fmac_f32 v99, v115, v125
  v_fmac_f32 v106, v119, v124
  v_fmac_f32 v107, v119, v125
  v_lshlrev_b32 v122, 16, v64
  v_and_b32 v123, 0xffff0000, v64
  v_fmac_f32 v92, v116, v122
  v_fmac_f32 v93, v116, v123
  v_fmac_f32 v100, v120, v122
  v_fmac_f32 v101, v120, v123
  v_lshlrev_b32 v124, 16, v65
  v_and_b32 v125, 0xffff0000, v65
  v_fmac_f32 v94, v116, v124
  v_fmac_f32 v95, v116, v125
  v_fmac_f32 v102, v120, v124
  v_fmac_f32 v103, v120, v125
  v_lshlrev_b32 v122, 16, v66
  v_and_b32 v123, 0xffff0000, v66
  v_fmac_f32 v96, v116, v122
  v_fmac_f32 v97, v116, v123
  v_fmac_f32 v104, v120, v122
  v_fmac_f32 v105, v120, v123
  v_lshlrev_b32 v124, 16, v67
  v_and_b32 v125, 0xffff0000, v67
  v_fmac_f32 v98, v116, v124
  v_fmac_f32 v99, v116, v125
  v_fmac_f32 v106, v120, v124
  v_fmac_f32 v107, v120, v125
  v_lshlrev_b32 v122, 16, v68
  v_and_b32 v123, 0xffff0000, v68
  v_fmac_f32 v92, v117, v122
  v_fmac_f32 v93, v117, v123
  v_fmac_f32 v100, v121, v122
  v_fmac_f32 v101, v121, v123
  v_lshlrev_b32 v124, 16, v69
  v_and_b32 v125, 0xffff0000, v69
  v_fmac_f32 v94, v117, v124
  v_fmac_f32 v95, v117, v125
  v_fmac_f32 v102, v121, v124
  v_fmac_f32 v103, v121, v125
  v_lshlrev_b32 v122, 16, v70
  v_and_b32 v123, 0xffff0000, v70
  v_fmac_f32 v96, v117, v122
  v_fmac_f32 v97, v117, v123
  v_fmac_f32 v104, v121, v122
  v_fmac_f32 v105, v121, v123
  v_lshlrev_b32 v124, 16, v71
  v_and_b32 v125, 0xffff0000, v71
  v_fmac_f32 v98, v117, v124
  v_fmac_f32 v99, v117, v125
  v_fmac_f32 v106, v121, v124
  v_fmac_f32 v107, v121, v125
  s_add_u32 s33, s31, 393216
  buffer_load_dwordx4 v[56:59], v6, s[20:23], s33 offen offset:0 nt
  buffer_load_dwordx4 v[60:63], v6, s[20:23], s33 offen offset:256 nt
  buffer_load_dwordx4 v[64:67], v6, s[20:23], s33 offen offset:512 nt
  buffer_load_dwordx4 v[68:71], v6, s[20:23], s33 offen offset:768 nt
  s_waitcnt vmcnt(12)
  v_mfma_f32_16x16x32_bf16 v[88:91], v[40:43], v[8:11], 0
  v_mfma_f32_16x16x32_bf16 v[88:91], v[44:47], v[12:15], v[88:91]
  v_mfma_f32_16x16x32_bf16 v[88:91], v[48:51], v[16:19], v[88:91]
  v_mfma_f32_16x16x32_bf16 v[88:91], v[52:55], v[20:23], v[88:91]
  s_add_u32 s33, s31, 458752
  buffer_load_dwordx4 v[40:43], v5, s[16:19], s33 offen offset:0 nt
  buffer_load_dwordx4 v[44:47], v5, s[16:19], s33 offen offset:64 nt
  buffer_load_dwordx4 v[48:51], v5, s[16:19], s33 offen offset:128 nt
  buffer_load_dwordx4 v[52:55], v5, s[16:19], s33 offen offset:192 nt
  s_nop 3
  s_nop 1
  v_max_f32 v112, v88, v89
  v_max3_f32 v112, v112, v90, v91
  v_max_f32 v112, v108, v112
  v_sub_f32 v113, v108, v112
  v_mul_f32 v113, s32, v113
  v_exp_f32 v110, v113
  v_mov_b32 v108, v112
  v_mul_f32 v113, s32, v112
  v_fma_f32 v114, v88, s32, -v113
  v_fma_f32 v115, v89, s32, -v113
  v_fma_f32 v116, v90, s32, -v113
  v_fma_f32 v117, v91, s32, -v113
  v_exp_f32 v114, v114
  v_exp_f32 v115, v115
  v_exp_f32 v116, v116
  v_exp_f32 v117, v117
  v_mov_b32_dpp v111, v110 quad_perm:[1,0,3,2] row_mask:0xf bank_mask:0xf
  v_mul_f32 v109, v109, v110
  v_mov_b32_dpp v118, v114 quad_perm:[1,0,3,2] row_mask:0xf bank_mask:0xf
  v_mov_b32_dpp v119, v115 quad_perm:[1,0,3,2] row_mask:0xf bank_mask:0xf
  v_mov_b32_dpp v120, v116 quad_perm:[1,0,3,2] row_mask:0xf bank_mask:0xf
  v_mov_b32_dpp v121, v117 quad_perm:[1,0,3,2] row_mask:0xf bank_mask:0xf
  v_add_f32 v112, v114, v115
  v_add_f32 v113, v116, v117
  v_add_f32 v112, v112, v113
  v_add_f32 v109, v109, v112
  v_mul_f32 v92, v92, v110
  v_mul_f32 v93, v93, v110
  v_mul_f32 v94, v94, v110
  v_mul_f32 v95, v95, v110
  v_mul_f32 v96, v96, v110
  v_mul_f32 v97, v97, v110
  v_mul_f32 v98, v98, v110
  v_mul_f32 v99, v99, v110
  v_mul_f32 v100, v100, v111
  v_mul_f32 v101, v101, v111
  v_mul_f32 v102, v102, v111
  v_mul_f32 v103, v103, v111
  v_mul_f32 v104, v104, v111
  v_mul_f32 v105, v105, v111
  v_mul_f32 v106, v106, v111
  v_mul_f32 v107, v107, v111
  s_waitcnt vmcnt(12)
  v_lshlrev_b32 v122, 16, v72
  v_and_b32 v123, 0xffff0000, v72
  v_fmac_f32 v92, v114, v122
  v_fmac_f32 v93, v114, v123
  v_fmac_f32 v100, v118, v122
  v_fmac_f32 v101, v118, v123
  v_lshlrev_b32 v124, 16, v73
  v_and_b32 v125, 0xffff0000, v73
  v_fmac_f32 v94, v114, v124
  v_fmac_f32 v95, v114, v125
  v_fmac_f32 v102, v118, v124
  v_fmac_f32 v103, v118, v125
  v_lshlrev_b32 v122, 16, v74
  v_and_b32 v123, 0xffff0000, v74
  v_fmac_f32 v96, v114, v122
  v_fmac_f32 v97, v114, v123
  v_fmac_f32 v104, v118, v122
  v_fmac_f32 v105, v118, v123
  v_lshlrev_b32 v124, 16, v75
  v_and_b32 v125, 0xffff0000, v75
  v_fmac_f32 v98, v114, v124
  v_fmac_f32 v99, v114, v125
  v_fmac_f32 v106, v118, v124
  v_fmac_f32 v107, v118, v125
  v_lshlrev_b32 v122, 16, v76
  v_and_b32 v123, 0xffff0000, v76
  v_fmac_f32 v92, v115, v122
  v_fmac_f32 v93, v115, v123
  v_fmac_f32 v100, v119, v122
  v_fmac_f32 v101, v119, v123
  v_lshlrev_b32 v124, 16, v77
  v_and_b32 v125, 0xffff0000, v77
  v_fmac_f32 v94, v115, v124
  v_fmac_f32 v95, v115, v125
  v_fmac_f32 v102, v119, v124
  v_fmac_f32 v103, v119, v125
  v_lshlrev_b32 v122, 16, v78
  v_and_b32 v123, 0xffff0000, v78
  v_fmac_f32 v96, v115, v122
  v_fmac_f32 v97, v115, v123
  v_fmac_f32 v104, v119, v122
  v_fmac_f32 v105, v119, v123
  v_lshlrev_b32 v124, 16, v79
  v_and_b32 v125, 0xffff0000, v79
  v_fmac_f32 v98, v115, v124
  v_fmac_f32 v99, v115, v125
  v_fmac_f32 v106, v119, v124
  v_fmac_f32 v107, v119, v125
  v_lshlrev_b32 v122, 16, v80
  v_and_b32 v123, 0xffff0000, v80
  v_fmac_f32 v92, v116, v122
  v_fmac_f32 v93, v116, v123
  v_fmac_f32 v100, v120, v122
  v_fmac_f32 v101, v120, v123
  v_lshlrev_b32 v124, 16, v81
  v_and_b32 v125, 0xffff0000, v81
  v_fmac_f32 v94, v116, v124
  v_fmac_f32 v95, v116, v125
  v_fmac_f32 v102, v120, v124
  v_fmac_f32 v103, v120, v125
  v_lshlrev_b32 v122, 16, v82
  v_and_b32 v123, 0xffff0000, v82
  v_fmac_f32 v96, v116, v122
  v_fmac_f32 v97, v116, v123
  v_fmac_f32 v104, v120, v122
  v_fmac_f32 v105, v120, v123
  v_lshlrev_b32 v124, 16, v83
  v_and_b32 v125, 0xffff0000, v83
  v_fmac_f32 v98, v116, v124
  v_fmac_f32 v99, v116, v125
  v_fmac_f32 v106, v120, v124
  v_fmac_f32 v107, v120, v125
  v_lshlrev_b32 v122, 16, v84
  v_and_b32 v123, 0xffff0000, v84
  v_fmac_f32 v92, v117, v122
  v_fmac_f32 v93, v117, v123
  v_fmac_f32 v100, v121, v122
  v_fmac_f32 v101, v121, v123
  v_lshlrev_b32 v124, 16, v85
  v_and_b32 v125, 0xffff0000, v85
  v_fmac_f32 v94, v117, v124
  v_fmac_f32 v95, v117, v125
  v_fmac_f32 v102, v121, v124
  v_fmac_f32 v103, v121, v125
  v_lshlrev_b32 v122, 16, v86
  v_and_b32 v123, 0xffff0000, v86
  v_fmac_f32 v96, v117, v122
  v_fmac_f32 v97, v117, v123
  v_fmac_f32 v104, v121, v122
  v_fmac_f32 v105, v121, v123
  v_lshlrev_b32 v124, 16, v87
  v_and_b32 v125, 0xffff0000, v87
  v_fmac_f32 v98, v117, v124
  v_fmac_f32 v99, v117, v125
  v_fmac_f32 v106, v121, v124
  v_fmac_f32 v107, v121, v125
  s_add_u32 s33, s31, 458752
  buffer_load_dwordx4 v[72:75], v6, s[20:23], s33 offen offset:0 nt
  buffer_load_dwordx4 v[76:79], v6, s[20:23], s33 offen offset:256 nt
  buffer_load_dwordx4 v[80:83], v6, s[20:23], s33 offen offset:512 nt
  buffer_load_dwordx4 v[84:87], v6, s[20:23], s33 offen offset:768 nt
  s_waitcnt vmcnt(12)
  v_mfma_f32_16x16x32_bf16 v[88:91], v[24:27], v[8:11], 0
  v_mfma_f32_16x16x32_bf16 v[88:91], v[28:31], v[12:15], v[88:91]
  v_mfma_f32_16x16x32_bf16 v[88:91], v[32:35], v[16:19], v[88:91]
  v_mfma_f32_16x16x32_bf16 v[88:91], v[36:39], v[20:23], v[88:91]
  s_nop 7
  s_nop 1
  v_max_f32 v112, v88, v89
  v_max3_f32 v112, v112, v90, v91
  v_max_f32 v112, v108, v112
  v_sub_f32 v113, v108, v112
  v_mul_f32 v113, s32, v113
  v_exp_f32 v110, v113
  v_mov_b32 v108, v112
  v_mul_f32 v113, s32, v112
  v_fma_f32 v114, v88, s32, -v113
  v_fma_f32 v115, v89, s32, -v113
  v_fma_f32 v116, v90, s32, -v113
  v_fma_f32 v117, v91, s32, -v113
  v_exp_f32 v114, v114
  v_exp_f32 v115, v115
  v_exp_f32 v116, v116
  v_exp_f32 v117, v117
  v_mov_b32_dpp v111, v110 quad_perm:[1,0,3,2] row_mask:0xf bank_mask:0xf
  v_mul_f32 v109, v109, v110
  v_mov_b32_dpp v118, v114 quad_perm:[1,0,3,2] row_mask:0xf bank_mask:0xf
  v_mov_b32_dpp v119, v115 quad_perm:[1,0,3,2] row_mask:0xf bank_mask:0xf
  v_mov_b32_dpp v120, v116 quad_perm:[1,0,3,2] row_mask:0xf bank_mask:0xf
  v_mov_b32_dpp v121, v117 quad_perm:[1,0,3,2] row_mask:0xf bank_mask:0xf
  v_add_f32 v112, v114, v115
  v_add_f32 v113, v116, v117
  v_add_f32 v112, v112, v113
  v_add_f32 v109, v109, v112
  v_mul_f32 v92, v92, v110
  v_mul_f32 v93, v93, v110
  v_mul_f32 v94, v94, v110
  v_mul_f32 v95, v95, v110
  v_mul_f32 v96, v96, v110
  v_mul_f32 v97, v97, v110
  v_mul_f32 v98, v98, v110
  v_mul_f32 v99, v99, v110
  v_mul_f32 v100, v100, v111
  v_mul_f32 v101, v101, v111
  v_mul_f32 v102, v102, v111
  v_mul_f32 v103, v103, v111
  v_mul_f32 v104, v104, v111
  v_mul_f32 v105, v105, v111
  v_mul_f32 v106, v106, v111
  v_mul_f32 v107, v107, v111
  s_waitcnt vmcnt(8)
  v_lshlrev_b32 v122, 16, v56
  v_and_b32 v123, 0xffff0000, v56
  v_fmac_f32 v92, v114, v122
  v_fmac_f32 v93, v114, v123
  v_fmac_f32 v100, v118, v122
  v_fmac_f32 v101, v118, v123
  v_lshlrev_b32 v124, 16, v57
  v_and_b32 v125, 0xffff0000, v57
  v_fmac_f32 v94, v114, v124
  v_fmac_f32 v95, v114, v125
  v_fmac_f32 v102, v118, v124
  v_fmac_f32 v103, v118, v125
  v_lshlrev_b32 v122, 16, v58
  v_and_b32 v123, 0xffff0000, v58
  v_fmac_f32 v96, v114, v122
  v_fmac_f32 v97, v114, v123
  v_fmac_f32 v104, v118, v122
  v_fmac_f32 v105, v118, v123
  v_lshlrev_b32 v124, 16, v59
  v_and_b32 v125, 0xffff0000, v59
  v_fmac_f32 v98, v114, v124
  v_fmac_f32 v99, v114, v125
  v_fmac_f32 v106, v118, v124
  v_fmac_f32 v107, v118, v125
  v_lshlrev_b32 v122, 16, v60
  v_and_b32 v123, 0xffff0000, v60
  v_fmac_f32 v92, v115, v122
  v_fmac_f32 v93, v115, v123
  v_fmac_f32 v100, v119, v122
  v_fmac_f32 v101, v119, v123
  v_lshlrev_b32 v124, 16, v61
  v_and_b32 v125, 0xffff0000, v61
  v_fmac_f32 v94, v115, v124
  v_fmac_f32 v95, v115, v125
  v_fmac_f32 v102, v119, v124
  v_fmac_f32 v103, v119, v125
  v_lshlrev_b32 v122, 16, v62
  v_and_b32 v123, 0xffff0000, v62
  v_fmac_f32 v96, v115, v122
  v_fmac_f32 v97, v115, v123
  v_fmac_f32 v104, v119, v122
  v_fmac_f32 v105, v119, v123
  v_lshlrev_b32 v124, 16, v63
  v_and_b32 v125, 0xffff0000, v63
  v_fmac_f32 v98, v115, v124
  v_fmac_f32 v99, v115, v125
  v_fmac_f32 v106, v119, v124
  v_fmac_f32 v107, v119, v125
  v_lshlrev_b32 v122, 16, v64
  v_and_b32 v123, 0xffff0000, v64
  v_fmac_f32 v92, v116, v122
  v_fmac_f32 v93, v116, v123
  v_fmac_f32 v100, v120, v122
  v_fmac_f32 v101, v120, v123
  v_lshlrev_b32 v124, 16, v65
  v_and_b32 v125, 0xffff0000, v65
  v_fmac_f32 v94, v116, v124
  v_fmac_f32 v95, v116, v125
  v_fmac_f32 v102, v120, v124
  v_fmac_f32 v103, v120, v125
  v_lshlrev_b32 v122, 16, v66
  v_and_b32 v123, 0xffff0000, v66
  v_fmac_f32 v96, v116, v122
  v_fmac_f32 v97, v116, v123
  v_fmac_f32 v104, v120, v122
  v_fmac_f32 v105, v120, v123
  v_lshlrev_b32 v124, 16, v67
  v_and_b32 v125, 0xffff0000, v67
  v_fmac_f32 v98, v116, v124
  v_fmac_f32 v99, v116, v125
  v_fmac_f32 v106, v120, v124
  v_fmac_f32 v107, v120, v125
  v_lshlrev_b32 v122, 16, v68
  v_and_b32 v123, 0xffff0000, v68
  v_fmac_f32 v92, v117, v122
  v_fmac_f32 v93, v117, v123
  v_fmac_f32 v100, v121, v122
  v_fmac_f32 v101, v121, v123
  v_lshlrev_b32 v124, 16, v69
  v_and_b32 v125, 0xffff0000, v69
  v_fmac_f32 v94, v117, v124
  v_fmac_f32 v95, v117, v125
  v_fmac_f32 v102, v121, v124
  v_fmac_f32 v103, v121, v125
  v_lshlrev_b32 v122, 16, v70
  v_and_b32 v123, 0xffff0000, v70
  v_fmac_f32 v96, v117, v122
  v_fmac_f32 v97, v117, v123
  v_fmac_f32 v104, v121, v122
  v_fmac_f32 v105, v121, v123
  v_lshlrev_b32 v124, 16, v71
  v_and_b32 v125, 0xffff0000, v71
  v_fmac_f32 v98, v117, v124
  v_fmac_f32 v99, v117, v125
  v_fmac_f32 v106, v121, v124
  v_fmac_f32 v107, v121, v125
  s_waitcnt vmcnt(4)
  v_mfma_f32_16x16x32_bf16 v[88:91], v[40:43], v[8:11], 0
  v_mfma_f32_16x16x32_bf16 v[88:91], v[44:47], v[12:15], v[88:91]
  v_mfma_f32_16x16x32_bf16 v[88:91], v[48:51], v[16:19], v[88:91]
  v_mfma_f32_16x16x32_bf16 v[88:91], v[52:55], v[20:23], v[88:91]
  s_nop 7
  s_nop 1
  v_max_f32 v112, v88, v89
  v_max3_f32 v112, v112, v90, v91
  v_max_f32 v112, v108, v112
  v_sub_f32 v113, v108, v112
  v_mul_f32 v113, s32, v113
  v_exp_f32 v110, v113
  v_mov_b32 v108, v112
  v_mul_f32 v113, s32, v112
  v_fma_f32 v114, v88, s32, -v113
  v_fma_f32 v115, v89, s32, -v113
  v_fma_f32 v116, v90, s32, -v113
  v_fma_f32 v117, v91, s32, -v113
  v_exp_f32 v114, v114
  v_exp_f32 v115, v115
  v_exp_f32 v116, v116
  v_exp_f32 v117, v117
  v_mov_b32_dpp v111, v110 quad_perm:[1,0,3,2] row_mask:0xf bank_mask:0xf
  v_mul_f32 v109, v109, v110
  v_mov_b32_dpp v118, v114 quad_perm:[1,0,3,2] row_mask:0xf bank_mask:0xf
  v_mov_b32_dpp v119, v115 quad_perm:[1,0,3,2] row_mask:0xf bank_mask:0xf
  v_mov_b32_dpp v120, v116 quad_perm:[1,0,3,2] row_mask:0xf bank_mask:0xf
  v_mov_b32_dpp v121, v117 quad_perm:[1,0,3,2] row_mask:0xf bank_mask:0xf
  v_add_f32 v112, v114, v115
  v_add_f32 v113, v116, v117
  v_add_f32 v112, v112, v113
  v_add_f32 v109, v109, v112
  v_mul_f32 v92, v92, v110
  v_mul_f32 v93, v93, v110
  v_mul_f32 v94, v94, v110
  v_mul_f32 v95, v95, v110
  v_mul_f32 v96, v96, v110
  v_mul_f32 v97, v97, v110
  v_mul_f32 v98, v98, v110
  v_mul_f32 v99, v99, v110
  v_mul_f32 v100, v100, v111
  v_mul_f32 v101, v101, v111
  v_mul_f32 v102, v102, v111
  v_mul_f32 v103, v103, v111
  v_mul_f32 v104, v104, v111
  v_mul_f32 v105, v105, v111
  v_mul_f32 v106, v106, v111
  v_mul_f32 v107, v107, v111
  s_waitcnt vmcnt(0)
  v_lshlrev_b32 v122, 16, v72
  v_and_b32 v123, 0xffff0000, v72
  v_fmac_f32 v92, v114, v122
  v_fmac_f32 v93, v114, v123
  v_fmac_f32 v100, v118, v122
  v_fmac_f32 v101, v118, v123
  v_lshlrev_b32 v124, 16, v73
  v_and_b32 v125, 0xffff0000, v73
  v_fmac_f32 v94, v114, v124
  v_fmac_f32 v95, v114, v125
  v_fmac_f32 v102, v118, v124
  v_fmac_f32 v103, v118, v125
  v_lshlrev_b32 v122, 16, v74
  v_and_b32 v123, 0xffff0000, v74
  v_fmac_f32 v96, v114, v122
  v_fmac_f32 v97, v114, v123
  v_fmac_f32 v104, v118, v122
  v_fmac_f32 v105, v118, v123
  v_lshlrev_b32 v124, 16, v75
  v_and_b32 v125, 0xffff0000, v75
  v_fmac_f32 v98, v114, v124
  v_fmac_f32 v99, v114, v125
  v_fmac_f32 v106, v118, v124
  v_fmac_f32 v107, v118, v125
  v_lshlrev_b32 v122, 16, v76
  v_and_b32 v123, 0xffff0000, v76
  v_fmac_f32 v92, v115, v122
  v_fmac_f32 v93, v115, v123
  v_fmac_f32 v100, v119, v122
  v_fmac_f32 v101, v119, v123
  v_lshlrev_b32 v124, 16, v77
  v_and_b32 v125, 0xffff0000, v77
  v_fmac_f32 v94, v115, v124
  v_fmac_f32 v95, v115, v125
  v_fmac_f32 v102, v119, v124
  v_fmac_f32 v103, v119, v125
  v_lshlrev_b32 v122, 16, v78
  v_and_b32 v123, 0xffff0000, v78
  v_fmac_f32 v96, v115, v122
  v_fmac_f32 v97, v115, v123
  v_fmac_f32 v104, v119, v122
  v_fmac_f32 v105, v119, v123
  v_lshlrev_b32 v124, 16, v79
  v_and_b32 v125, 0xffff0000, v79
  v_fmac_f32 v98, v115, v124
  v_fmac_f32 v99, v115, v125
  v_fmac_f32 v106, v119, v124
  v_fmac_f32 v107, v119, v125
  v_lshlrev_b32 v122, 16, v80
  v_and_b32 v123, 0xffff0000, v80
  v_fmac_f32 v92, v116, v122
  v_fmac_f32 v93, v116, v123
  v_fmac_f32 v100, v120, v122
  v_fmac_f32 v101, v120, v123
  v_lshlrev_b32 v124, 16, v81
  v_and_b32 v125, 0xffff0000, v81
  v_fmac_f32 v94, v116, v124
  v_fmac_f32 v95, v116, v125
  v_fmac_f32 v102, v120, v124
  v_fmac_f32 v103, v120, v125
  v_lshlrev_b32 v122, 16, v82
  v_and_b32 v123, 0xffff0000, v82
  v_fmac_f32 v96, v116, v122
  v_fmac_f32 v97, v116, v123
  v_fmac_f32 v104, v120, v122
  v_fmac_f32 v105, v120, v123
  v_lshlrev_b32 v124, 16, v83
  v_and_b32 v125, 0xffff0000, v83
  v_fmac_f32 v98, v116, v124
  v_fmac_f32 v99, v116, v125
  v_fmac_f32 v106, v120, v124
  v_fmac_f32 v107, v120, v125
  v_lshlrev_b32 v122, 16, v84
  v_and_b32 v123, 0xffff0000, v84
  v_fmac_f32 v92, v117, v122
  v_fmac_f32 v93, v117, v123
  v_fmac_f32 v100, v121, v122
  v_fmac_f32 v101, v121, v123
  v_lshlrev_b32 v124, 16, v85
  v_and_b32 v125, 0xffff0000, v85
  v_fmac_f32 v94, v117, v124
  v_fmac_f32 v95, v117, v125
  v_fmac_f32 v102, v121, v124
  v_fmac_f32 v103, v121, v125
  v_lshlrev_b32 v122, 16, v86
  v_and_b32 v123, 0xffff0000, v86
  v_fmac_f32 v96, v117, v122
  v_fmac_f32 v97, v117, v123
  v_fmac_f32 v104, v121, v122
  v_fmac_f32 v105, v121, v123
  v_lshlrev_b32 v124, 16, v87
  v_and_b32 v125, 0xffff0000, v87
  v_fmac_f32 v98, v117, v124
  v_fmac_f32 v99, v117, v125
  v_fmac_f32 v106, v121, v124
  v_fmac_f32 v107, v121, v125
  v_xor_b32 v122, 16, v2
  v_lshlrev_b32 v122, 2, v122
  v_xor_b32 v123, 32, v2
  v_lshlrev_b32 v123, 2, v123
  ds_bpermute_b32 v112, v122, v108
  s_waitcnt lgkmcnt(0)
  v_max_f32 v112, v112, v108
  ds_bpermute_b32 v113, v123, v112
  s_waitcnt lgkmcnt(0)
  v_max_f32 v112, v112, v113
  v_sub_f32 v113, v108, v112
  v_mul_f32 v113, s32, v113
  v_exp_f32 v110, v113
  v_mul_f32 v108, s32, v112
  s_nop 1
  v_mov_b32_dpp v111, v110 quad_perm:[1,0,3,2] row_mask:0xf bank_mask:0xf
  v_mul_f32 v109, v109, v110
  v_mul_f32 v92, v92, v110
  v_mul_f32 v93, v93, v110
  v_mul_f32 v94, v94, v110
  v_mul_f32 v95, v95, v110
  v_mul_f32 v96, v96, v110
  v_mul_f32 v97, v97, v110
  v_mul_f32 v98, v98, v110
  v_mul_f32 v99, v99, v110
  v_mul_f32 v100, v100, v111
  v_mul_f32 v101, v101, v111
  v_mul_f32 v102, v102, v111
  v_mul_f32 v103, v103, v111
  v_mul_f32 v104, v104, v111
  v_mul_f32 v105, v105, v111
  v_mul_f32 v106, v106, v111
  v_mul_f32 v107, v107, v111
  ds_bpermute_b32 v24, v122, v109
  ds_bpermute_b32 v25, v122, v92
  ds_bpermute_b32 v26, v122, v93
  ds_bpermute_b32 v27, v122, v94
  ds_bpermute_b32 v28, v122, v95
  ds_bpermute_b32 v29, v122, v96
  ds_bpermute_b32 v30, v122, v97
  ds_bpermute_b32 v31, v122, v98
  ds_bpermute_b32 v32, v122, v99
  ds_bpermute_b32 v33, v122, v100
  ds_bpermute_b32 v34, v122, v101
  ds_bpermute_b32 v35, v122, v102
  ds_bpermute_b32 v36, v122, v103
  ds_bpermute_b32 v37, v122, v104
  ds_bpermute_b32 v38, v122, v105
  ds_bpermute_b32 v39, v122, v106
  ds_bpermute_b32 v40, v122, v107
  s_waitcnt lgkmcnt(0)
  v_add_f32 v109, v109, v24
  v_add_f32 v92, v92, v25
  v_add_f32 v93, v93, v26
  v_add_f32 v94, v94, v27
  v_add_f32 v95, v95, v28
  v_add_f32 v96, v96, v29
  v_add_f32 v97, v97, v30
  v_add_f32 v98, v98, v31
  v_add_f32 v99, v99, v32
  v_add_f32 v100, v100, v33
  v_add_f32 v101, v101, v34
  v_add_f32 v102, v102, v35
  v_add_f32 v103, v103, v36
  v_add_f32 v104, v104, v37
  v_add_f32 v105, v105, v38
  v_add_f32 v106, v106, v39
  v_add_f32 v107, v107, v40
  ds_bpermute_b32 v24, v123, v109
  ds_bpermute_b32 v25, v123, v92
  ds_bpermute_b32 v26, v123, v93
  ds_bpermute_b32 v27, v123, v94
  ds_bpermute_b32 v28, v123, v95
  ds_bpermute_b32 v29, v123, v96
  ds_bpermute_b32 v30, v123, v97
  ds_bpermute_b32 v31, v123, v98
  ds_bpermute_b32 v32, v123, v99
  ds_bpermute_b32 v33, v123, v100
  ds_bpermute_b32 v34, v123, v101
  ds_bpermute_b32 v35, v123, v102
  ds_bpermute_b32 v36, v123, v103
  ds_bpermute_b32 v37, v123, v104
  ds_bpermute_b32 v38, v123, v105
  ds_bpermute_b32 v39, v123, v106
  ds_bpermute_b32 v40, v123, v107
  s_waitcnt lgkmcnt(0)
  v_add_f32 v109, v109, v24
  v_add_f32 v92, v92, v25
  v_add_f32 v93, v93, v26
  v_add_f32 v94, v94, v27
  v_add_f32 v95, v95, v28
  v_add_f32 v96, v96, v29
  v_add_f32 v97, v97, v30
  v_add_f32 v98, v98, v31
  v_add_f32 v99, v99, v32
  v_add_f32 v100, v100, v33
  v_add_f32 v101, v101, v34
  v_add_f32 v102, v102, v35
  v_add_f32 v103, v103, v36
  v_add_f32 v104, v104, v37
  v_add_f32 v105, v105, v38
  v_add_f32 v106, v106, v39
  v_add_f32 v107, v107, v40
  v_cmp_gt_u32 vcc, 16, v2
  s_and_saveexec_b64 s[36:37], vcc
  s_lshl_b32 s33, s30, 10
  v_and_b32 v112, 1, v2
  v_lshlrev_b32 v112, 9, v112
  v_lshl_add_u32 v112, v3, 5, v112
  v_add_u32 v112, s33, v112
  v_xor_b32 v113, 512, v112
  ds_write_b128 v112, v[92:95]
  ds_write_b128 v112, v[96:99] offset:16
  ds_write_b128 v113, v[100:103]
  ds_write_b128 v113, v[104:107] offset:16
  s_lshl_b32 s33, s30, 4
  s_add_u32 s33, s33, 16384
  v_lshlrev_b32 v112, 3, v2
  v_add_u32 v112, s33, v112
  v_cmp_gt_u32 vcc, 2, v2
  s_and_b64 exec, exec, vcc
  ds_write_b64 v112, v[108:109]
  s_mov_b64 exec, s[36:37]
  s_waitcnt lgkmcnt(0)
  s_barrier
  s_cmp_ge_u32 s30, 4
  s_cbranch_scc1 L_end
  v_lshrrev_b32 v8, 7, v0
  v_lshlrev_b32 v16, 2, v2
  v_lshl_add_u32 v17, v8, 8, v16
  buffer_load_dword v18, v17, s[12:15], s34 offen
  s_lshl_b32 s35, s28, 8
  buffer_load_dword v19, v16, s[52:55], s35 offen
  v_and_b32 v14, 127, v0
  v_lshlrev_b32 v20, 1, v14
  buffer_load_ushort v21, v20, s[56:59], s35 offen
  s_lshr_b32 s35, s28, 4
  s_lshl_b32 s35, s35, 1
  v_mov_b32 v22, 0
  buffer_load_ushort v23, v22, s[60:63], s35 offen
  v_lshlrev_b32 v9, 3, v8
  v_add_u32 v9, 16384, v9
  ds_read_b64 v[24:25], v9 offset:0
  ds_read_b64 v[26:27], v9 offset:16
  ds_read_b64 v[28:29], v9 offset:32
  ds_read_b64 v[30:31], v9 offset:48
  ds_read_b64 v[32:33], v9 offset:64
  ds_read_b64 v[34:35], v9 offset:80
  ds_read_b64 v[36:37], v9 offset:96
  ds_read_b64 v[38:39], v9 offset:112
  ds_read_b64 v[40:41], v9 offset:128
  ds_read_b64 v[42:43], v9 offset:144
  ds_read_b64 v[44:45], v9 offset:160
  ds_read_b64 v[46:47], v9 offset:176
  ds_read_b64 v[48:49], v9 offset:192
  ds_read_b64 v[50:51], v9 offset:208
  ds_read_b64 v[52:53], v9 offset:224
  ds_read_b64 v[54:55], v9 offset:240
  v_lshlrev_b32 v10, 2, v0
  ds_read_b32 v64, v10 offset:0
  ds_read_b32 v65, v10 offset:1024
  ds_read_b32 v66, v10 offset:2048
  ds_read_b32 v67, v10 offset:3072
  ds_read_b32 v68, v10 offset:4096
  ds_read_b32 v69, v10 offset:5120
  ds_read_b32 v70, v10 offset:6144
  ds_read_b32 v71, v10 offset:7168
  ds_read_b32 v72, v10 offset:8192
  ds_read_b32 v73, v10 offset:9216
  ds_read_b32 v74, v10 offset:10240
  ds_read_b32 v75, v10 offset:11264
  ds_read_b32 v76, v10 offset:12288
  ds_read_b32 v77, v10 offset:13312
  ds_read_b32 v78, v10 offset:14336
  ds_read_b32 v79, v10 offset:15360
  s_waitcnt lgkmcnt(0)
  v_mov_b32 v12, v24
  v_max_f32 v12, v12, v26
  v_max_f32 v12, v12, v28
  v_max_f32 v12, v12, v30
  v_max_f32 v12, v12, v32
  v_max_f32 v12, v12, v34
  v_max_f32 v12, v12, v36
  v_max_f32 v12, v12, v38
  v_max_f32 v12, v12, v40
  v_max_f32 v12, v12, v42
  v_max_f32 v12, v12, v44
  v_max_f32 v12, v12, v46
  v_max_f32 v12, v12, v48
  v_max_f32 v12, v12, v50
  v_max_f32 v12, v12, v52
  v_max_f32 v12, v12, v54
  v_sub_f32 v24, v24, v12
  v_sub_f32 v26, v26, v12
  v_sub_f32 v28, v28, v12
  v_sub_f32 v30, v30, v12
  v_sub_f32 v32, v32, v12
  v_sub_f32 v34, v34, v12
  v_sub_f32 v36, v36, v12
  v_sub_f32 v38, v38, v12
  v_sub_f32 v40, v40, v12
  v_sub_f32 v42, v42, v12
  v_sub_f32 v44, v44, v12
  v_sub_f32 v46, v46, v12
  v_sub_f32 v48, v48, v12
  v_sub_f32 v50, v50, v12
  v_sub_f32 v52, v52, v12
  v_sub_f32 v54, v54, v12
  v_exp_f32 v24, v24
  v_exp_f32 v26, v26
  v_exp_f32 v28, v28
  v_exp_f32 v30, v30
  v_exp_f32 v32, v32
  v_exp_f32 v34, v34
  v_exp_f32 v36, v36
  v_exp_f32 v38, v38
  v_exp_f32 v40, v40
  v_exp_f32 v42, v42
  v_exp_f32 v44, v44
  v_exp_f32 v46, v46
  v_exp_f32 v48, v48
  v_exp_f32 v50, v50
  v_exp_f32 v52, v52
  v_exp_f32 v54, v54
  v_mov_b32 v13, 0
  v_mov_b32 v15, 0
  v_fmac_f32 v13, v24, v25
  v_fmac_f32 v15, v24, v64
  v_fmac_f32 v13, v26, v27
  v_fmac_f32 v15, v26, v65
  v_fmac_f32 v13, v28, v29
  v_fmac_f32 v15, v28, v66
  v_fmac_f32 v13, v30, v31
  v_fmac_f32 v15, v30, v67
  v_fmac_f32 v13, v32, v33
  v_fmac_f32 v15, v32, v68
  v_fmac_f32 v13, v34, v35
  v_fmac_f32 v15, v34, v69
  v_fmac_f32 v13, v36, v37
  v_fmac_f32 v15, v36, v70
  v_fmac_f32 v13, v38, v39
  v_fmac_f32 v15, v38, v71
  v_fmac_f32 v13, v40, v41
  v_fmac_f32 v15, v40, v72
  v_fmac_f32 v13, v42, v43
  v_fmac_f32 v15, v42, v73
  v_fmac_f32 v13, v44, v45
  v_fmac_f32 v15, v44, v74
  v_fmac_f32 v13, v46, v47
  v_fmac_f32 v15, v46, v75
  v_fmac_f32 v13, v48, v49
  v_fmac_f32 v15, v48, v76
  v_fmac_f32 v13, v50, v51
  v_fmac_f32 v15, v50, v77
  v_fmac_f32 v13, v52, v53
  v_fmac_f32 v15, v52, v78
  v_fmac_f32 v13, v54, v55
  v_fmac_f32 v15, v54, v79
  s_lshl_b32 s33, s2, 10
  buffer_store_dword v15, v10, s[24:27], s33 offen sc1
  v_cmp_eq_u32 vcc, 0, v14
  s_and_saveexec_b64 s[36:37], vcc
  s_lshl_b32 s33, s2, 4
  s_add_u32 s33, s33, 245760
  buffer_store_dwordx2 v[12:13], v9, s[24:27], s33 offen sc1
  s_mov_b64 exec, s[36:37]
  s_waitcnt vmcnt(4)
  v_lshlrev_b32 v24, 16, v18
  v_and_b32 v25, 0xffff0000, v18
  v_lshlrev_b32 v26, 16, v19
  v_and_b32 v27, 0xffff0000, v19
  v_mul_f32 v24, v24, v26
  v_fmac_f32 v24, v25, v27
  v_xor_b32 v25, 1, v2
  v_lshlrev_b32 v25, 2, v25
  ds_bpermute_b32 v26, v25, v24
  s_waitcnt lgkmcnt(0)
  v_add_f32 v24, v24, v26
  v_xor_b32 v25, 2, v2
  v_lshlrev_b32 v25, 2, v25
  ds_bpermute_b32 v26, v25, v24
  s_waitcnt lgkmcnt(0)
  v_add_f32 v24, v24, v26
  v_xor_b32 v25, 4, v2
  v_lshlrev_b32 v25, 2, v25
  ds_bpermute_b32 v26, v25, v24
  s_waitcnt lgkmcnt(0)
  v_add_f32 v24, v24, v26
  v_xor_b32 v25, 8, v2
  v_lshlrev_b32 v25, 2, v25
  ds_bpermute_b32 v26, v25, v24
  s_waitcnt lgkmcnt(0)
  v_add_f32 v24, v24, v26
  v_xor_b32 v25, 16, v2
  v_lshlrev_b32 v25, 2, v25
  ds_bpermute_b32 v26, v25, v24
  s_waitcnt lgkmcnt(0)
  v_add_f32 v24, v24, v26
  v_xor_b32 v25, 32, v2
  v_lshlrev_b32 v25, 2, v25
  ds_bpermute_b32 v26, v25, v24
  s_waitcnt lgkmcnt(0)
  v_add_f32 v24, v24, v26
  s_waitcnt vmcnt(0)
  s_barrier
  s_cmp_lg_u32 s30, 0
  s_cbranch_scc1 L_wait
  v_mov_b32 v26, 1
  v_mov_b32 v27, 0
  s_lshl_b32 s33, s28, 2
  v_cmp_eq_u32 vcc, 0, v2
  s_and_saveexec_b64 s[36:37], vcc
  buffer_atomic_add v26, v27, s[68:71], s33 offen sc0 sc1
  s_waitcnt vmcnt(0)
  v_mov_b32 v27, 16640
  ds_write_b32 v27, v26
  s_waitcnt lgkmcnt(0)
  s_mov_b64 exec, s[36:37]
L_wait:
  s_barrier
  v_mov_b32 v27, 16640
  ds_read_b32 v26, v27
  s_waitcnt lgkmcnt(0)
  v_readfirstlane_b32 s33, v26
  s_nop 3
  s_cmp_lg_u32 s33, 7
  s_cbranch_scc1 L_end
  s_mul_i32 s35, s28, 8192
  s_add_u32 s33, s35, 0
  buffer_load_dword v64, v10, s[24:27], s33 offen sc1
  s_add_u32 s33, s35, 1024
  buffer_load_dword v65, v10, s[24:27], s33 offen sc1
  s_add_u32 s33, s35, 2048
  buffer_load_dword v66, v10, s[24:27], s33 offen sc1
  s_add_u32 s33, s35, 3072
  buffer_load_dword v67, v10, s[24:27], s33 offen sc1
  s_add_u32 s33, s35, 4096
  buffer_load_dword v68, v10, s[24:27], s33 offen sc1
  s_add_u32 s33, s35, 5120
  buffer_load_dword v69, v10, s[24:27], s33 offen sc1
  s_add_u32 s33, s35, 6144
  buffer_load_dword v70, v10, s[24:27], s33 offen sc1
  s_add_u32 s33, s35, 7168
  buffer_load_dword v71, v10, s[24:27], s33 offen sc1
  s_mul_i32 s35, s28, 128
  s_add_u32 s35, s35, 245760
  s_add_u32 s33, s35, 0
  buffer_load_dwordx2 v[32:33], v9, s[24:27], s33 offen sc1
  s_add_u32 s33, s35, 16
  buffer_load_dwordx2 v[34:35], v9, s[24:27], s33 offen sc1
  s_add_u32 s33, s35, 32
  buffer_load_dwordx2 v[36:37], v9, s[24:27], s33 offen sc1
  s_add_u32 s33, s35, 48
  buffer_load_dwordx2 v[38:39], v9, s[24:27], s33 offen sc1
  s_add_u32 s33, s35, 64
  buffer_load_dwordx2 v[40:41], v9, s[24:27], s33 offen sc1
  s_add_u32 s33, s35, 80
  buffer_load_dwordx2 v[42:43], v9, s[24:27], s33 offen sc1
  s_add_u32 s33, s35, 96
  buffer_load_dwordx2 v[44:45], v9, s[24:27], s33 offen sc1
  s_add_u32 s33, s35, 112
  buffer_load_dwordx2 v[46:47], v9, s[24:27], s33 offen sc1
  v_lshlrev_b32 v23, 16, v23
  v_sub_f32 v23, 1.0, v23
  v_mul_f32 v23, 0xceabfb8f, v23
  v_fma_f32 v24, v24, s32, v23
  v_lshlrev_b32 v21, 16, v21
  s_waitcnt vmcnt(0)
  v_mov_b32 v12, v24
  v_max_f32 v12, v12, v32
  v_max_f32 v12, v12, v34
  v_max_f32 v12, v12, v36
  v_max_f32 v12, v12, v38
  v_max_f32 v12, v12, v40
  v_max_f32 v12, v12, v42
  v_max_f32 v12, v12, v44
  v_max_f32 v12, v12, v46
  v_sub_f32 v13, v24, v12
  v_exp_f32 v13, v13
  v_sub_f32 v32, v32, v12
  v_sub_f32 v34, v34, v12
  v_sub_f32 v36, v36, v12
  v_sub_f32 v38, v38, v12
  v_sub_f32 v40, v40, v12
  v_sub_f32 v42, v42, v12
  v_sub_f32 v44, v44, v12
  v_sub_f32 v46, v46, v12
  v_exp_f32 v32, v32
  v_exp_f32 v34, v34
  v_exp_f32 v36, v36
  v_exp_f32 v38, v38
  v_exp_f32 v40, v40
  v_exp_f32 v42, v42
  v_exp_f32 v44, v44
  v_exp_f32 v46, v46
  v_mul_f32 v15, v13, v21
  v_fmac_f32 v15, v32, v64
  v_fmac_f32 v13, v32, v33
  v_fmac_f32 v15, v34, v65
  v_fmac_f32 v13, v34, v35
  v_fmac_f32 v15, v36, v66
  v_fmac_f32 v13, v36, v37
  v_fmac_f32 v15, v38, v67
  v_fmac_f32 v13, v38, v39
  v_fmac_f32 v15, v40, v68
  v_fmac_f32 v13, v40, v41
  v_fmac_f32 v15, v42, v69
  v_fmac_f32 v13, v42, v43
  v_fmac_f32 v15, v44, v70
  v_fmac_f32 v13, v44, v45
  v_fmac_f32 v15, v46, v71
  v_fmac_f32 v13, v46, v47
  v_rcp_f32 v13, v13
  s_nop 0
  v_mul_f32 v15, v15, v13
  v_cvt_pk_bf16_f32 v15, v15, v15
  v_lshlrev_b32 v20, 1, v0
  buffer_store_short v15, v20, s[64:67], s34 offen
L_end:
  s_endpgm
.section .rodata,"a"
.p2align 6
.amdhsa_kernel standalone__tree_speculative_verify_tree_attention_over_candidate_token_tree__decode_kernel
  .amdhsa_next_free_vgpr 128
  .amdhsa_next_free_sgpr 80
  .amdhsa_accum_offset 128
  .amdhsa_group_segment_fixed_size 0
  .amdhsa_kernarg_size 72
  .amdhsa_user_sgpr_count 2
  .amdhsa_user_sgpr_kernarg_segment_ptr 1
  .amdhsa_system_sgpr_workgroup_id_x 1
.end_amdhsa_kernel
```
